```python
import torch

def _softmax(x, axis=-1):
    return torch.softmax(x, dim=axis)
def _gelu(x):
    return torch.nn.functional.gelu(x, approximate="tanh")
def _silu(x):
    return torch.nn.functional.silu(x)
def _sigmoid(x):
    return torch.sigmoid(x)
def _layernorm(x, axis=-1, eps=1e-5):
    m = x.mean(dim=axis, keepdim=True)
    v = x.var(dim=axis, keepdim=True, unbiased=False)
    return (x - m) / torch.sqrt(v + eps)
def _scatter_add(tgt, idx, src, axis=0):
    return tgt.clone().index_add_(axis, idx, src)
def _segment_sum(src, seg, n):
    out = torch.zeros((n,) + src.shape[1:], dtype=src.dtype)
    return out.index_add_(0, seg, src)
def _pad(x, pw):
    flat = tuple(v for pair in reversed(pw) for v in pair)
    return torch.nn.functional.pad(x, flat)

kernel_name = 'gated_mix__gqa_block_cached__glu_gated_glu__decode'

def setup_inputs():

    _w = (lambda a: (lambda t: t.to(torch.bfloat16) if t.is_floating_point() else t)(torch.as_tensor(a)))
    def _A_setup():
        B, Sq, D = 4, 1, 512
        Hq, Hkv, Sk, Dh = 32, 8, 4096, 128
        assert Hq % Hkv == 0, (Hq, Hkv)
        return {
            "x": _w((lambda *s: torch.randn(*s, dtype=torch.bfloat16) * 0.05)(B, Sq, D)),
            "k_cache": _w((lambda *s: torch.randn(*s, dtype=torch.bfloat16) * 6.4)(B, Hkv, Sk, Dh)),
            "v_cache": _w((lambda *s: torch.randn(*s, dtype=torch.bfloat16) * 1.6)(B, Hkv, Sk, Dh)),
            "wq": _w((lambda *s: torch.randn(*s, dtype=torch.bfloat16) * 6.4)(D, Hq * Dh) * (D ** -0.5)),
            "wo": _w((lambda *s: torch.randn(*s, dtype=torch.bfloat16) * 1.6)(Hq * Dh, D) * ((Hq * Dh) ** -0.5)),
        }
    _A_in = _A_setup()

    def _B_setup():
        B, S, D, F = 4, 1, 512, 1792
        return {
            "x": _w((lambda *s: torch.randn(*s, dtype=torch.bfloat16) * 0.05)(B, S, D)),
            "w_gate": _w((lambda *s: torch.randn(*s, dtype=torch.bfloat16) * 3.2)(D, F)),
            "w_up": _w((lambda *s: torch.randn(*s, dtype=torch.bfloat16) * 0.1)(D, F)),
            "w_down": _w((lambda *s: torch.randn(*s, dtype=torch.bfloat16) * 0.1)(F, D)),
        }
    _B_in = _B_setup()

    return {
        "A_x": _A_in["x"],
        "A_k_cache": _A_in["k_cache"],
        "A_v_cache": _A_in["v_cache"],
        "A_wq": _A_in["wq"],
        "A_wo": _A_in["wo"],
        "B_x": _B_in["x"],
        "B_w_gate": _B_in["w_gate"],
        "B_w_up": _B_in["w_up"],
        "B_w_down": _B_in["w_down"],
        "gate_w": _w((lambda *s: torch.randn(*s, dtype=torch.bfloat16) * 0.05)(512) * 16.0),
    }

def reference(A_x, A_k_cache, A_v_cache, A_wq, A_wo, B_x, B_w_gate, B_w_up, B_w_down, gate_w):
    def _A_ref(x, k_cache, v_cache, wq, wo):
        B, Sq, D = x.shape
        Hq, Dh = 32, 128
        Hkv = k_cache.shape[1]
        rep = Hq // Hkv
        q = (lambda x, *d: x.permute(*d))((x @ wq).reshape(B, Sq, Hq, Dh), 0, 2, 1, 3)
        k = (lambda x, n, axis: torch.repeat_interleave(x, n, dim=axis))(k_cache, rep, axis=1)
        v = (lambda x, n, axis: torch.repeat_interleave(x, n, dim=axis))(v_cache, rep, axis=1)
        scores = torch.einsum("bhqd,bhkd->bhqk", q, k) * (Dh ** -0.5)
        p = _softmax(scores, axis=-1)
        o = torch.einsum("bhqk,bhkd->bhqd", p, v)
        return (lambda x, *d: x.permute(*d))(o, 0, 2, 1, 3).reshape(B, Sq, Hq * Dh) @ wo

    def _B_ref(x, w_gate, w_up, w_down):
        g = torch.einsum("bsd,df->bsf", x, w_gate)
        u = torch.einsum("bsd,df->bsf", x, w_up)
        h = _sigmoid(g) * u
        return torch.einsum("bsf,fd->bsd", h, w_down)

    x = A_x
    g = _sigmoid((x * gate_w).sum(-1, keepdims=True))
    a = _A_ref(x, A_k_cache, A_v_cache, A_wq, A_wo)
    b = _B_ref(x, B_w_gate, B_w_up, B_w_down)
    return g * a + (1 - g) * b
```

```asm
; @launch grid=(256,1,1) block=(512,1,1) lds=53008
.amdgcn_target "amdgcn-amd-amdhsa--gfx950"
.text
.globl gated_mix__gqa_block_cached__glu_gated_glu__decode_kernel
.p2align 8
.type gated_mix__gqa_block_cached__glu_gated_glu__decode_kernel,@function
gated_mix__gqa_block_cached__glu_gated_glu__decode_kernel:
s_cmp_ge_u32 s2, 256
s_cbranch_scc1 L_end
s_load_dwordx16 s[8:23], s[0:1], 0
s_load_dwordx8 s[24:31], s[0:1], 64
s_load_dwordx2 s[32:33], s[0:1], 96
s_getpc_b64 s[4:5]
L_pc0:
v_subrev_u32 v4, 384, v0
v_cmp_gt_u32 vcc, (L_end-L_pc0)/128, v4
v_lshlrev_b32 v4, 7, v4
s_and_saveexec_b64 s[6:7], vcc
s_cbranch_execz L_pfdone
global_load_dword v255, v4, s[4:5]
L_pfdone:
s_mov_b64 exec, s[6:7]
v_and_b32 v1, 63, v0
v_lshrrev_b32 v4, 6, v0
s_and_b32 s34, s2, 7
s_lshr_b32 s35, s2, 3
v_readfirstlane_b32 s3, v4
s_lshr_b32 s36, s35, 3
s_and_b32 s37, s35, 7
s_lshl_b32 s38, s34, 2
s_add_u32 s38, s38, s36
v_lshrrev_b32 v2, 4, v1
v_and_b32 v3, 15, v1
s_and_b32 s39, s3, 3
s_lshl_b32 s60, s36, 3
s_add_u32 s60, s60, s34
s_lshl_b32 s60, s60, 20
s_lshl_b32 s61, s37, 5
s_lshl_b32 s62, s39, 1
s_add_u32 s61, s61, s62
s_lshl_b32 s61, s61, 12
s_add_u32 s60, s60, s61
s_cmp_ge_u32 s3, 4
s_cbranch_scc1 L_vpath
v_lshlrev_b32 v4, 8, v3
v_lshlrev_b32 v5, 4, v2
v_add_u32 v4, v4, v5
v_lshlrev_b32 v6, 2, v1
v_mov_b32 v7, 0
s_mov_b64 exec, 63
ds_write_b32 v6, v7 offset:42128
s_mov_b64 exec, -1
s_waitcnt lgkmcnt(0)
s_mov_b32 s40, s10
s_mov_b32 s41, s11
s_mov_b32 s42, 0x2000000
s_mov_b32 s43, 0x20000
s_mov_b32 s56, s30
s_mov_b32 s57, s31
s_mov_b32 s58, 0x100
s_mov_b32 s59, 0x20000
v_and_b32 v15, 0x38, v1
v_lshlrev_b32 v15, 2, v15
s_add_u32 s62, s60, 0
buffer_load_dwordx4 v[64:67], v4, s[40:43], s62 offen offset:0 nt
buffer_load_dwordx4 v[68:71], v4, s[40:43], s62 offen offset:64 nt
buffer_load_dwordx4 v[72:75], v4, s[40:43], s62 offen offset:128 nt
buffer_load_dwordx4 v[76:79], v4, s[40:43], s62 offen offset:192 nt
s_barrier
s_waitcnt vmcnt(3)
s_add_u32 s62, s60, 4096
buffer_load_dwordx4 v[80:83], v4, s[40:43], s62 offen offset:0 nt
s_waitcnt vmcnt(3)
buffer_load_dwordx4 v[84:87], v4, s[40:43], s62 offen offset:64 nt
s_waitcnt vmcnt(3)
buffer_load_dwordx4 v[88:91], v4, s[40:43], s62 offen offset:128 nt
s_waitcnt vmcnt(3)
buffer_load_dwordx4 v[92:95], v4, s[40:43], s62 offen offset:192 nt
s_waitcnt vmcnt(3)
s_add_u32 s62, s60, 32768
buffer_load_dwordx4 v[96:99], v4, s[40:43], s62 offen offset:0 nt
s_waitcnt vmcnt(3)
buffer_load_dwordx4 v[100:103], v4, s[40:43], s62 offen offset:64 nt
s_waitcnt vmcnt(3)
buffer_load_dwordx4 v[104:107], v4, s[40:43], s62 offen offset:128 nt
s_waitcnt vmcnt(3)
buffer_load_dwordx4 v[108:111], v4, s[40:43], s62 offen offset:192 nt
s_waitcnt vmcnt(3)
s_add_u32 s62, s60, 36864
buffer_load_dwordx4 v[112:115], v4, s[40:43], s62 offen offset:0 nt
s_waitcnt vmcnt(3)
buffer_load_dwordx4 v[116:119], v4, s[40:43], s62 offen offset:64 nt
s_waitcnt vmcnt(3)
buffer_load_dwordx4 v[120:123], v4, s[40:43], s62 offen offset:128 nt
s_waitcnt vmcnt(3)
buffer_load_dwordx4 v[124:127], v4, s[40:43], s62 offen offset:192 nt
s_waitcnt vmcnt(3)
s_add_u32 s62, s60, 65536
buffer_load_dwordx4 v[128:131], v4, s[40:43], s62 offen offset:0 nt
s_waitcnt vmcnt(3)
buffer_load_dwordx4 v[132:135], v4, s[40:43], s62 offen offset:64 nt
s_waitcnt vmcnt(3)
buffer_load_dwordx4 v[136:139], v4, s[40:43], s62 offen offset:128 nt
s_waitcnt vmcnt(3)
buffer_load_dwordx4 v[140:143], v4, s[40:43], s62 offen offset:192 nt
s_waitcnt vmcnt(3)
s_add_u32 s62, s60, 69632
buffer_load_dwordx4 v[144:147], v4, s[40:43], s62 offen offset:0 nt
s_waitcnt vmcnt(3)
buffer_load_dwordx4 v[148:151], v4, s[40:43], s62 offen offset:64 nt
s_waitcnt vmcnt(3)
buffer_load_dwordx4 v[152:155], v4, s[40:43], s62 offen offset:128 nt
s_waitcnt vmcnt(3)
buffer_load_dwordx4 v[156:159], v4, s[40:43], s62 offen offset:192 nt
s_waitcnt vmcnt(3)
s_add_u32 s62, s60, 98304
buffer_load_dwordx4 v[160:163], v4, s[40:43], s62 offen offset:0 nt
s_waitcnt vmcnt(3)
buffer_load_dwordx4 v[164:167], v4, s[40:43], s62 offen offset:64 nt
s_waitcnt vmcnt(3)
buffer_load_dwordx4 v[168:171], v4, s[40:43], s62 offen offset:128 nt
buffer_load_dword v6, v15, s[56:59], 0 offen sc1
s_waitcnt vmcnt(4)
buffer_load_dwordx4 v[172:175], v4, s[40:43], s62 offen offset:192 nt
s_waitcnt vmcnt(4)
s_add_u32 s62, s60, 102400
buffer_load_dwordx4 v[176:179], v4, s[40:43], s62 offen offset:0 nt
s_waitcnt vmcnt(4)
buffer_load_dwordx4 v[180:183], v4, s[40:43], s62 offen offset:64 nt
s_waitcnt vmcnt(3)
buffer_load_dwordx4 v[184:187], v4, s[40:43], s62 offen offset:128 nt
s_waitcnt vmcnt(3)
buffer_load_dwordx4 v[188:191], v4, s[40:43], s62 offen offset:192 nt
s_barrier
s_mov_b32 s44, s32
s_mov_b32 s45, s33
s_mov_b32 s46, 0x200000
s_mov_b32 s47, 0x20000
s_waitcnt vmcnt(5)
v_and_b32 v7, 63, v6
v_cmp_ne_u32 vcc, 32, v7
s_cbranch_vccz L_kpoll_done
s_cmp_lg_u32 s3, 0
s_cbranch_scc1 L_kwaitf
s_mov_b32 s63, 65536
L_kpoll:
buffer_load_dword v6, v15, s[56:59], 0 offen sc1
s_waitcnt vmcnt(0)
v_and_b32 v7, 63, v6
v_cmp_ne_u32 vcc, 32, v7
s_cbranch_vccz L_kpoll_done
s_sub_u32 s63, s63, 1
s_cmp_eq_u32 s63, 0
s_cbranch_scc1 L_kpoll_done
s_sleep 16
s_branch L_kpoll
L_kpoll_done:
s_getreg_b32 s66, hwreg(HW_REG_XCC_ID, 0, 4)
s_mul_i32 s67, s66, s66
s_lshl_b32 s67, s67, 14
s_lshl_b32 s66, s66, 6
s_add_u32 s66, s66, s67
s_add_u32 s66, s66, 1
s_lshl_b32 s66, s66, 5
s_lshl_b32 s67, s34, 3
v_readlane_b32 s67, v6, s67
s_nop 3
s_cmp_eq_u32 s66, s67
s_cselect_b32 s71, 1, 0
s_cmp_lg_u32 s3, 0
s_cbranch_scc1 L_kgo
v_mov_b32 v8, 42148
v_mov_b32 v9, s71
ds_write_b32 v8, v9
v_mov_b32 v8, 42144
v_mov_b32 v9, 1
s_mov_b64 exec, 1
ds_add_u32 v8, v9
s_mov_b64 exec, -1
s_branch L_kgo
L_kwaitf:
v_mov_b32 v8, 42144
s_mov_b32 s63, 524288
L_lw1:
ds_read_b32 v9, v8
s_waitcnt lgkmcnt(0)
v_cmp_gt_u32 vcc, 1, v9
s_cbranch_vccz L_lwd1
s_sub_u32 s63, s63, 1
s_cmp_eq_u32 s63, 0
s_cbranch_scc1 L_lwd1
s_sleep 1
s_branch L_lw1
L_lwd1:
v_mov_b32 v8, 42148
ds_read_b32 v9, v8
s_waitcnt lgkmcnt(0)
v_readfirstlane_b32 s71, v9
L_kgo:
v_lshlrev_b32 v5, 3, v1
s_lshl_b32 s62, s36, 16
s_lshl_b32 s63, s34, 13
s_add_u32 s62, s62, s63
s_lshl_b32 s63, s39, 11
s_add_u32 s62, s62, s63
s_add_u32 s62, s62, 0
buffer_load_dwordx2 v[16:17], v5, s[44:47], s62 offen offset:0 sc1
buffer_load_dwordx2 v[18:19], v5, s[44:47], s62 offen offset:512 sc1
buffer_load_dwordx2 v[20:21], v5, s[44:47], s62 offen offset:1024 sc1
buffer_load_dwordx2 v[22:23], v5, s[44:47], s62 offen offset:1536 sc1
v_lshlrev_b32 v7, 2, v1
s_min_u32 s62, s38, 27
s_lshl_b32 s62, s62, 13
s_lshl_b32 s63, s39, 11
s_add_u32 s62, s62, s63
s_add_u32 s62, s62, 262144
buffer_load_dword v192, v7, s[44:47], s62 offen offset:0 sc1
buffer_load_dword v193, v7, s[44:47], s62 offen offset:256 sc1
buffer_load_dword v194, v7, s[44:47], s62 offen offset:512 sc1
buffer_load_dword v195, v7, s[44:47], s62 offen offset:768 sc1
buffer_load_dword v196, v7, s[44:47], s62 offen offset:1024 sc1
buffer_load_dword v197, v7, s[44:47], s62 offen offset:1280 sc1
buffer_load_dword v198, v7, s[44:47], s62 offen offset:1536 sc1
buffer_load_dword v199, v7, s[44:47], s62 offen offset:1792 sc1
s_lshl_b32 s62, s39, 8
s_add_u32 s62, s62, 51472
v_add_u32 v7, s62, v7
v_lshlrev_b32 v6, 2, v2
v_and_b32 v10, 3, v3
v_add_u32 v6, v6, v10
v_mul_u32_u24 v6, 36, v6
v_lshrrev_b32 v10, 2, v3
v_add_u32 v6, v6, v10
v_lshlrev_b32 v6, 2, v6
s_mul_i32 s62, s39, 2304
s_add_u32 s62, s62, 32768
v_add_u32 v6, s62, v6
v_lshrrev_b32 v5, 2, v3
v_lshlrev_b32 v5, 8, v5
v_lshlrev_b32 v10, 4, v2
v_add_u32 v5, v5, v10
s_waitcnt vmcnt(8)
v_add_f32 v16, v16, v18
v_add_f32 v17, v17, v19
v_add_f32 v20, v20, v22
v_add_f32 v21, v21, v23
v_add_f32 v16, v16, v20
v_add_f32 v17, v17, v21
v_cvt_pk_bf16_f32 v16, v16, v17
ds_write_b32 v7, v16
v_mov_b32 v8, 42132
v_mov_b32 v9, 1
s_mov_b64 exec, 1
ds_add_u32 v8, v9
s_mov_b64 exec, -1
v_mov_b32 v8, 42132
s_mov_b32 s63, 524288
L_lw2:
ds_read_b32 v9, v8
s_waitcnt lgkmcnt(0)
v_cmp_gt_u32 vcc, 4, v9
s_cbranch_vccz L_lwd2
s_sub_u32 s63, s63, 1
s_cmp_eq_u32 s63, 0
s_cbranch_scc1 L_lwd2
s_branch L_lw2
L_lwd2:
ds_read_b128 v[16:19], v5 offset:51472
ds_read_b128 v[20:23], v5 offset:51536
ds_read_b128 v[24:27], v5 offset:51600
ds_read_b128 v[28:31], v5 offset:51664
s_waitcnt lgkmcnt(0)
v_mfma_f32_16x16x32_bf16 v[32:35], v[16:19], v[64:67], 0
v_mfma_f32_16x16x32_bf16 v[36:39], v[16:19], v[80:83], 0
v_mfma_f32_16x16x32_bf16 v[40:43], v[16:19], v[96:99], 0
v_mfma_f32_16x16x32_bf16 v[44:47], v[16:19], v[112:115], 0
v_mfma_f32_16x16x32_bf16 v[48:51], v[16:19], v[128:131], 0
v_mfma_f32_16x16x32_bf16 v[52:55], v[16:19], v[144:147], 0
v_mfma_f32_16x16x32_bf16 v[56:59], v[16:19], v[160:163], 0
v_mfma_f32_16x16x32_bf16 v[60:63], v[16:19], v[176:179], 0
v_mfma_f32_16x16x32_bf16 v[32:35], v[20:23], v[68:71], v[32:35]
v_mfma_f32_16x16x32_bf16 v[36:39], v[20:23], v[84:87], v[36:39]
v_mfma_f32_16x16x32_bf16 v[40:43], v[20:23], v[100:103], v[40:43]
v_mfma_f32_16x16x32_bf16 v[44:47], v[20:23], v[116:119], v[44:47]
v_mfma_f32_16x16x32_bf16 v[48:51], v[20:23], v[132:135], v[48:51]
v_mfma_f32_16x16x32_bf16 v[52:55], v[20:23], v[148:151], v[52:55]
v_mfma_f32_16x16x32_bf16 v[56:59], v[20:23], v[164:167], v[56:59]
v_mfma_f32_16x16x32_bf16 v[60:63], v[20:23], v[180:183], v[60:63]
v_mfma_f32_16x16x32_bf16 v[32:35], v[24:27], v[72:75], v[32:35]
v_mfma_f32_16x16x32_bf16 v[36:39], v[24:27], v[88:91], v[36:39]
v_mfma_f32_16x16x32_bf16 v[40:43], v[24:27], v[104:107], v[40:43]
v_mfma_f32_16x16x32_bf16 v[44:47], v[24:27], v[120:123], v[44:47]
v_mfma_f32_16x16x32_bf16 v[48:51], v[24:27], v[136:139], v[48:51]
v_mfma_f32_16x16x32_bf16 v[52:55], v[24:27], v[152:155], v[52:55]
v_mfma_f32_16x16x32_bf16 v[56:59], v[24:27], v[168:171], v[56:59]
v_mfma_f32_16x16x32_bf16 v[60:63], v[24:27], v[184:187], v[60:63]
v_mfma_f32_16x16x32_bf16 v[32:35], v[28:31], v[76:79], v[32:35]
v_mfma_f32_16x16x32_bf16 v[36:39], v[28:31], v[92:95], v[36:39]
v_mfma_f32_16x16x32_bf16 v[40:43], v[28:31], v[108:111], v[40:43]
v_mfma_f32_16x16x32_bf16 v[44:47], v[28:31], v[124:127], v[44:47]
v_mfma_f32_16x16x32_bf16 v[48:51], v[28:31], v[140:143], v[48:51]
v_mfma_f32_16x16x32_bf16 v[52:55], v[28:31], v[156:159], v[52:55]
v_mfma_f32_16x16x32_bf16 v[56:59], v[28:31], v[172:175], v[56:59]
v_mfma_f32_16x16x32_bf16 v[60:63], v[28:31], v[188:191], v[60:63]
s_nop 7
s_nop 1
s_mov_b32 s62, 0x3db504f3
s_mov_b32 s63, 0xffff0000
v_cvt_pk_bf16_f32 v33, v32, v36
v_cvt_pk_bf16_f32 v41, v40, v44
v_cvt_pk_bf16_f32 v49, v48, v52
v_cvt_pk_bf16_f32 v57, v56, v60
v_lshlrev_b32 v32, 16, v33
v_and_b32 v36, s63, v33
v_lshlrev_b32 v40, 16, v41
v_and_b32 v44, s63, v41
v_lshlrev_b32 v48, 16, v49
v_and_b32 v52, s63, v49
v_lshlrev_b32 v56, 16, v57
v_and_b32 v60, s63, v57
v_mul_f32 v32, s62, v32
v_mul_f32 v36, s62, v36
v_mul_f32 v40, s62, v40
v_mul_f32 v44, s62, v44
v_mul_f32 v48, s62, v48
v_mul_f32 v52, s62, v52
v_mul_f32 v56, s62, v56
v_mul_f32 v60, s62, v60
v_cvt_pk_bf16_f32 v33, v32, v36
v_cvt_pk_bf16_f32 v41, v40, v44
v_cvt_pk_bf16_f32 v49, v48, v52
v_cvt_pk_bf16_f32 v57, v56, v60
v_lshlrev_b32 v32, 16, v33
v_and_b32 v36, s63, v33
v_lshlrev_b32 v40, 16, v41
v_and_b32 v44, s63, v41
v_lshlrev_b32 v48, 16, v49
v_and_b32 v52, s63, v49
v_lshlrev_b32 v56, 16, v57
v_and_b32 v60, s63, v57
v_max3_f32 v8, v32, v36, v40
v_max3_f32 v9, v44, v48, v52
v_max3_f32 v8, v8, v56, v60
v_max_f32 v8, v8, v9
s_nop 1
v_max_f32_dpp v8, v8, v8 row_ror:8 row_mask:0xf bank_mask:0xf
s_nop 1
v_max_f32_dpp v8, v8, v8 row_ror:4 row_mask:0xf bank_mask:0xf
s_nop 1
v_max_f32_dpp v8, v8, v8 row_ror:2 row_mask:0xf bank_mask:0xf
s_nop 1
v_max_f32_dpp v8, v8, v8 row_ror:1 row_mask:0xf bank_mask:0xf
s_mov_b32 s62, 0x3fb8aa3b
v_mul_f32 v8, s62, v8
v_fma_f32 v32, v32, s62, -v8
v_fma_f32 v36, v36, s62, -v8
v_fma_f32 v40, v40, s62, -v8
v_fma_f32 v44, v44, s62, -v8
v_fma_f32 v48, v48, s62, -v8
v_fma_f32 v52, v52, s62, -v8
v_fma_f32 v56, v56, s62, -v8
v_fma_f32 v60, v60, s62, -v8
v_exp_f32 v32, v32
v_exp_f32 v36, v36
v_exp_f32 v40, v40
v_exp_f32 v44, v44
v_exp_f32 v48, v48
v_exp_f32 v52, v52
v_exp_f32 v56, v56
v_exp_f32 v60, v60
s_nop 0
v_cvt_pk_bf16_f32 v33, v32, v32
v_cvt_pk_bf16_f32 v37, v36, v36
v_cvt_pk_bf16_f32 v41, v40, v40
v_cvt_pk_bf16_f32 v45, v44, v44
v_cvt_pk_bf16_f32 v49, v48, v48
v_cvt_pk_bf16_f32 v53, v52, v52
v_cvt_pk_bf16_f32 v57, v56, v56
v_cvt_pk_bf16_f32 v61, v60, v60
ds_write_b32 v6, v33 offset:0
ds_write_b32 v6, v37 offset:16
ds_write_b32 v6, v41 offset:32
ds_write_b32 v6, v45 offset:48
ds_write_b32 v6, v49 offset:64
ds_write_b32 v6, v53 offset:80
ds_write_b32 v6, v57 offset:96
ds_write_b32 v6, v61 offset:112
v_add_f32 v9, v32, v36
v_add_f32 v10, v40, v44
v_add_f32 v11, v48, v52
v_add_f32 v12, v56, v60
v_add_f32 v9, v9, v10
v_add_f32 v11, v11, v12
v_add_f32 v9, v9, v11
s_nop 1
v_add_f32_dpp v9, v9, v9 row_ror:8 row_mask:0xf bank_mask:0xf
s_nop 1
v_add_f32_dpp v9, v9, v9 row_ror:4 row_mask:0xf bank_mask:0xf
s_nop 1
v_add_f32_dpp v9, v9, v9 row_ror:2 row_mask:0xf bank_mask:0xf
s_nop 1
v_add_f32_dpp v9, v9, v9 row_ror:1 row_mask:0xf bank_mask:0xf
v_lshlrev_b32 v10, 5, v2
s_lshl_b32 s62, s39, 3
s_add_u32 s62, s62, 41984
v_add_u32 v11, s62, v10
v_cmp_eq_u32 vcc, 0, v3
s_and_saveexec_b64 s[64:65], vcc
ds_write_b64 v11, v[8:9]
v_mov_b32 v12, 42136
v_mov_b32 v13, 1
s_mov_b64 exec, 1
ds_add_rtn_u32 v14, v12, v13
s_waitcnt lgkmcnt(0)
v_cmp_eq_u32 vcc, 3, v14
s_mov_b64 exec, -1
s_cbranch_vccz L_noml
ds_read_b128 v[16:19], v10 offset:41984
ds_read_b128 v[20:23], v10 offset:42000
s_waitcnt lgkmcnt(0)
v_max3_f32 v34, v16, v18, v20
v_max_f32 v34, v34, v22
v_sub_f32 v16, v16, v34
v_sub_f32 v18, v18, v34
v_sub_f32 v20, v20, v34
v_sub_f32 v22, v22, v34
v_exp_f32 v16, v16
v_exp_f32 v18, v18
v_exp_f32 v20, v20
v_exp_f32 v22, v22
s_nop 0
v_mul_f32 v35, v16, v17
v_fmac_f32 v35, v18, v19
v_fmac_f32 v35, v20, v21
v_fmac_f32 v35, v22, v23
s_mov_b32 s67, 0xfffffffe
v_min_u32 v34, s67, v34
v_min_u32 v35, s67, v35
v_lshlrev_b32 v13, 8, v2
s_lshl_b32 s62, s34, 10
s_lshl_b32 s63, s36, 6
s_add_u32 s62, s62, s63
s_lshl_b32 s63, s37, 3
s_add_u32 s62, s62, s63
s_add_u32 s62, s62, 491520
v_cmp_eq_u32 vcc, 0, v3
s_and_saveexec_b64 s[64:65], vcc
s_cmp_eq_u32 s71, 1
s_cbranch_scc1 L_ms3
buffer_store_dwordx2 v[34:35], v13, s[44:47], s62 offen sc1
s_branch L_msd3
L_ms3:
buffer_store_dwordx2 v[34:35], v13, s[44:47], s62 offen
L_msd3:
s_mov_b64 exec, s[64:65]
L_noml:
s_mov_b32 s48, s16
s_mov_b32 s49, s17
s_mov_b32 s50, 0x400000
s_mov_b32 s51, 0x20000
s_mov_b32 s52, s24
s_mov_b32 s53, s25
s_mov_b32 s54, 0x1c0000
s_mov_b32 s55, 0x20000
v_and_b32 v6, 3, v3
v_lshlrev_b32 v6, 2, v6
ds_read_b32 v12, v6 offset:42112
v_lshrrev_b32 v4, 3, v1
v_lshlrev_b32 v4, 10, v4
v_and_b32 v5, 7, v1
v_lshlrev_b32 v5, 4, v5
v_add_u32 v4, v4, v5
v_lshrrev_b32 v7, 2, v3
v_lshlrev_b32 v8, 3, v2
v_add_u32 v7, v7, v8
v_lshlrev_b32 v7, 7, v7
v_and_b32 v8, 3, v3
v_lshlrev_b32 v8, 3, v8
v_add_u32 v7, v7, v8
s_lshl_b32 s62, s39, 5
v_add_u32 v7, s62, v7
v_and_b32 v13, 7, v1
v_lshlrev_b32 v13, 3, v13
s_lshl_b32 s68, s34, 10
s_lshl_b32 s63, s36, 8
s_add_u32 s68, s68, s63
s_lshl_b32 s63, s39, 6
s_add_u32 s68, s68, s63
s_add_u32 s68, s68, 491520
v_lshlrev_b32 v5, 3, v1
s_lshl_b32 s66, s34, 16
s_lshl_b32 s63, s36, 14
s_add_u32 s66, s66, s63
s_lshl_b32 s63, s39, 12
s_add_u32 s66, s66, s63
s_add_u32 s66, s66, 524288
s_waitcnt lgkmcnt(0)
s_barrier
buffer_load_dwordx2 v[10:11], v13, s[44:47], s68 offen sc1
s_lshl_b32 s62, s38, 17
s_lshl_b32 s63, s37, 7
s_add_u32 s62, s62, s63
s_lshl_b32 s69, s39, 15
s_add_u32 s62, s62, s69
s_lshl_b32 s67, s39, 12
s_add_u32 s67, s67, 0
s_mov_b32 m0, s67
s_add_u32 s67, s67, 1024
buffer_load_dwordx4 v4, s[48:51], s62 offen nt lds
s_add_u32 s62, s62, 8192
s_mov_b32 m0, s67
s_add_u32 s67, s67, 1024
buffer_load_dwordx4 v4, s[48:51], s62 offen nt lds
s_add_u32 s62, s62, 8192
s_mov_b32 m0, s67
s_add_u32 s67, s67, 1024
buffer_load_dwordx4 v4, s[48:51], s62 offen nt lds
s_add_u32 s62, s62, 8192
s_mov_b32 m0, s67
s_add_u32 s67, s67, 1024
buffer_load_dwordx4 v4, s[48:51], s62 offen nt lds
s_add_u32 s62, s62, 8192
s_lshl_b32 s62, s38, 16
s_add_u32 s62, s62, s63
s_lshl_b32 s69, s39, 14
s_add_u32 s62, s62, s69
s_lshl_b32 s67, s39, 11
s_add_u32 s67, s67, 16384
s_mov_b32 m0, s67
s_add_u32 s67, s67, 1024
buffer_load_dwordx4 v4, s[52:55], s62 offen nt lds
s_add_u32 s62, s62, 8192
s_mov_b32 m0, s67
s_add_u32 s67, s67, 1024
buffer_load_dwordx4 v4, s[52:55], s62 offen nt lds
s_add_u32 s62, s62, 8192
s_waitcnt vmcnt(7)
v_add_f32 v24, v192, v193
v_add_f32 v26, v194, v195
v_add_f32 v28, v196, v197
v_add_f32 v30, v198, v199
v_add_f32 v24, v24, v26
v_add_f32 v28, v28, v30
v_cvt_pk_bf16_f32 v24, v24, v24
v_and_b32 v24, 0xffff0000, v24
v_cvt_pk_bf16_f32 v28, v28, v28
v_and_b32 v28, 0xffff0000, v28
v_mul_f32 v26, 0xbfb8aa3b, v24
v_exp_f32 v26, v26
s_nop 0
v_add_f32 v26, 1.0, v26
v_rcp_f32 v25, v26
s_nop 0
v_cvt_pk_bf16_f32 v25, v25, v25
v_and_b32 v25, 0xffff0000, v25
v_mul_f32 v25, v25, v28
v_cvt_pk_bf16_f32 v25, v25, v25
s_lshl_b32 s62, s39, 7
s_add_u32 s62, s62, 52496
v_lshlrev_b32 v9, 1, v1
v_add_u32 v9, s62, v9
ds_write_b16 v9, v25
v_and_b32 v8, 3, v3
v_lshlrev_b32 v8, 7, v8
v_lshlrev_b32 v9, 4, v2
v_add_u32 v8, v8, v9
s_waitcnt lgkmcnt(0)
s_barrier
ds_read_b128 v[64:67], v8 offset:52496
ds_read_b128 v[68:71], v8 offset:52560
buffer_load_dwordx2 v[120:121], v5, s[44:47], s66 offen offset:0 sc1
buffer_load_dwordx2 v[122:123], v5, s[44:47], s66 offen offset:512 sc1
buffer_load_dwordx2 v[124:125], v5, s[44:47], s66 offen offset:1024 sc1
buffer_load_dwordx2 v[126:127], v5, s[44:47], s66 offen offset:1536 sc1
buffer_load_dwordx2 v[128:129], v5, s[44:47], s66 offen offset:2048 sc1
buffer_load_dwordx2 v[130:131], v5, s[44:47], s66 offen offset:2560 sc1
buffer_load_dwordx2 v[132:133], v5, s[44:47], s66 offen offset:3072 sc1
buffer_load_dwordx2 v[134:135], v5, s[44:47], s66 offen offset:3584 sc1
s_waitcnt vmcnt(14)
s_mov_b32 s63, 65536
L_mlpoll:
v_max_u32 v14, v10, v11
v_cmp_eq_u32 vcc, -1, v14
s_cbranch_vccz L_mlpoll_done
s_sub_u32 s63, s63, 1
s_cmp_eq_u32 s63, 0
s_cbranch_scc1 L_mlpoll_done
buffer_load_dwordx2 v[10:11], v13, s[44:47], s68 offen sc1
s_waitcnt vmcnt(0)
s_branch L_mlpoll
L_mlpoll_done:
v_mov_b32 v14, v10
s_nop 1
v_max_f32_dpp v14, v14, v14 quad_perm:[1,0,3,2] row_mask:0xf bank_mask:0xf
s_nop 1
v_max_f32_dpp v14, v14, v14 quad_perm:[2,3,0,1] row_mask:0xf bank_mask:0xf
s_nop 1
v_max_f32_dpp v14, v14, v14 row_half_mirror row_mask:0xf bank_mask:0xf
v_sub_f32 v10, v10, v14
v_exp_f32 v10, v10
s_nop 0
v_mul_f32 v11, v10, v11
s_nop 1
v_add_f32_dpp v11, v11, v11 quad_perm:[1,0,3,2] row_mask:0xf bank_mask:0xf
s_nop 1
v_add_f32_dpp v11, v11, v11 quad_perm:[2,3,0,1] row_mask:0xf bank_mask:0xf
s_nop 1
v_add_f32_dpp v11, v11, v11 row_half_mirror row_mask:0xf bank_mask:0xf
v_rcp_f32 v11, v11
s_nop 0
v_mul_f32 v10, v10, v11
s_nop 0
v_readlane_b32 s72, v10, 0
v_readlane_b32 s73, v10, 1
v_readlane_b32 s74, v10, 2
v_readlane_b32 s75, v10, 3
v_readlane_b32 s76, v10, 4
v_readlane_b32 s77, v10, 5
v_readlane_b32 s78, v10, 6
v_readlane_b32 s79, v10, 7
s_waitcnt vmcnt(8)
buffer_load_dwordx2 v[136:137], v5, s[44:47], s66 offen offset:0 sc1
buffer_load_dwordx2 v[138:139], v5, s[44:47], s66 offen offset:512 sc1
buffer_load_dwordx2 v[140:141], v5, s[44:47], s66 offen offset:1024 sc1
buffer_load_dwordx2 v[142:143], v5, s[44:47], s66 offen offset:1536 sc1
buffer_load_dwordx2 v[144:145], v5, s[44:47], s66 offen offset:2048 sc1
buffer_load_dwordx2 v[146:147], v5, s[44:47], s66 offen offset:2560 sc1
buffer_load_dwordx2 v[148:149], v5, s[44:47], s66 offen offset:3072 sc1
buffer_load_dwordx2 v[150:151], v5, s[44:47], s66 offen offset:3584 sc1
v_mov_b32 v8, 42140
v_mov_b32 v9, 1
s_mov_b64 exec, 1
ds_add_u32 v8, v9
s_mov_b64 exec, -1
v_lshlrev_b32 v6, 13, v3
v_lshrrev_b32 v13, 1, v2
v_lshlrev_b32 v13, 10, v13
v_add_u32 v6, v6, v13
v_and_b32 v13, 1, v2
v_lshlrev_b32 v13, 4, v13
v_add_u32 v6, v6, v13
s_lshl_b32 s62, s37, 15
s_lshl_b32 s67, s39, 11
s_add_u32 s62, s62, s67
s_lshl_b32 s67, s38, 5
s_add_u32 s62, s62, s67
s_add_u32 s62, s62, 1048576
v_mov_b32 v8, 42140
s_mov_b32 s63, 524288
L_lw4:
ds_read_b32 v9, v8
s_waitcnt lgkmcnt(0)
v_cmp_gt_u32 vcc, 4, v9
s_cbranch_vccz L_lwd4
s_sub_u32 s63, s63, 1
s_cmp_eq_u32 s63, 0
s_cbranch_scc1 L_lwd4
s_branch L_lw4
L_lwd4:
ds_read_b64_tr_b16 v[88:89], v7 offset:16384
ds_read_b64_tr_b16 v[90:91], v7 offset:16896
ds_read_b64_tr_b16 v[92:93], v7 offset:20480
ds_read_b64_tr_b16 v[94:95], v7 offset:20992
ds_read_b64_tr_b16 v[72:73], v7 offset:0
ds_read_b64_tr_b16 v[74:75], v7 offset:512
ds_read_b64_tr_b16 v[76:77], v7 offset:4096
ds_read_b64_tr_b16 v[78:79], v7 offset:4608
ds_read_b64_tr_b16 v[80:81], v7 offset:8192
ds_read_b64_tr_b16 v[82:83], v7 offset:8704
ds_read_b64_tr_b16 v[84:85], v7 offset:12288
ds_read_b64_tr_b16 v[86:87], v7 offset:12800
v_lshlrev_b32 v7, 2, v1
s_lshl_b32 s67, s39, 8
s_add_u32 s67, s67, 50448
v_add_u32 v7, s67, v7
v_and_b32 v8, 3, v3
v_lshlrev_b32 v8, 8, v8
v_lshlrev_b32 v9, 4, v2
v_add_u32 v8, v8, v9
v_sub_f32 v13, 1.0, v12
s_waitcnt lgkmcnt(0)
v_mfma_f32_16x16x32_bf16 v[96:99], v[88:91], v[64:67], 0
v_mfma_f32_16x16x32_bf16 v[96:99], v[92:95], v[68:71], v[96:99]
s_mov_b32 s63, 65536
s_mov_b32 s67, 0xfffffffe
s_nop 5
v_mul_f32 v96, v13, v96
v_mul_f32 v97, v13, v97
v_mul_f32 v98, v13, v98
v_mul_f32 v99, v13, v99
L_opoll:
s_waitcnt vmcnt(8)
v_max3_u32 v10, v120, v121, v122
v_max3_u32 v11, v123, v124, v125
v_max3_u32 v10, v10, v126, v127
v_max3_u32 v11, v11, v128, v129
v_max3_u32 v10, v10, v130, v131
v_max3_u32 v11, v11, v132, v133
v_max3_u32 v10, v10, v134, v135
v_max_u32 v10, v10, v11
v_cmp_eq_u32 vcc, -1, v10
s_cbranch_vccz L_ogA
buffer_load_dwordx2 v[120:121], v5, s[44:47], s66 offen offset:0 sc1
buffer_load_dwordx2 v[122:123], v5, s[44:47], s66 offen offset:512 sc1
buffer_load_dwordx2 v[124:125], v5, s[44:47], s66 offen offset:1024 sc1
buffer_load_dwordx2 v[126:127], v5, s[44:47], s66 offen offset:1536 sc1
buffer_load_dwordx2 v[128:129], v5, s[44:47], s66 offen offset:2048 sc1
buffer_load_dwordx2 v[130:131], v5, s[44:47], s66 offen offset:2560 sc1
buffer_load_dwordx2 v[132:133], v5, s[44:47], s66 offen offset:3072 sc1
buffer_load_dwordx2 v[134:135], v5, s[44:47], s66 offen offset:3584 sc1
s_waitcnt vmcnt(8)
v_max3_u32 v10, v136, v137, v138
v_max3_u32 v11, v139, v140, v141
v_max3_u32 v10, v10, v142, v143
v_max3_u32 v11, v11, v144, v145
v_max3_u32 v10, v10, v146, v147
v_max3_u32 v11, v11, v148, v149
v_max3_u32 v10, v10, v150, v151
v_max_u32 v10, v10, v11
v_cmp_eq_u32 vcc, -1, v10
s_cbranch_vccz L_ogB
buffer_load_dwordx2 v[136:137], v5, s[44:47], s66 offen offset:0 sc1
buffer_load_dwordx2 v[138:139], v5, s[44:47], s66 offen offset:512 sc1
buffer_load_dwordx2 v[140:141], v5, s[44:47], s66 offen offset:1024 sc1
buffer_load_dwordx2 v[142:143], v5, s[44:47], s66 offen offset:1536 sc1
buffer_load_dwordx2 v[144:145], v5, s[44:47], s66 offen offset:2048 sc1
buffer_load_dwordx2 v[146:147], v5, s[44:47], s66 offen offset:2560 sc1
buffer_load_dwordx2 v[148:149], v5, s[44:47], s66 offen offset:3072 sc1
buffer_load_dwordx2 v[150:151], v5, s[44:47], s66 offen offset:3584 sc1
s_sub_u32 s63, s63, 1
s_cmp_lg_u32 s63, 0
s_cbranch_scc1 L_opoll
s_waitcnt vmcnt(0)
L_ogB:
v_mul_f32 v10, s72, v136
v_mul_f32 v11, s72, v137
v_fmac_f32 v10, s73, v138
v_fmac_f32 v11, s73, v139
v_fmac_f32 v10, s74, v140
v_fmac_f32 v11, s74, v141
v_fmac_f32 v10, s75, v142
v_fmac_f32 v11, s75, v143
v_fmac_f32 v10, s76, v144
v_fmac_f32 v11, s76, v145
v_fmac_f32 v10, s77, v146
v_fmac_f32 v11, s77, v147
v_fmac_f32 v10, s78, v148
v_fmac_f32 v11, s78, v149
v_fmac_f32 v10, s79, v150
v_fmac_f32 v11, s79, v151
s_branch L_ogot
L_ogA:
v_mul_f32 v10, s72, v120
v_mul_f32 v11, s72, v121
v_fmac_f32 v10, s73, v122
v_fmac_f32 v11, s73, v123
v_fmac_f32 v10, s74, v124
v_fmac_f32 v11, s74, v125
v_fmac_f32 v10, s75, v126
v_fmac_f32 v11, s75, v127
v_fmac_f32 v10, s76, v128
v_fmac_f32 v11, s76, v129
v_fmac_f32 v10, s77, v130
v_fmac_f32 v11, s77, v131
v_fmac_f32 v10, s78, v132
v_fmac_f32 v11, s78, v133
v_fmac_f32 v10, s79, v134
v_fmac_f32 v11, s79, v135
L_ogot:
v_cvt_pk_bf16_f32 v10, v10, v11
ds_write_b32 v7, v10
v_cmp_gt_u32 vcc, 4, v3
s_waitcnt lgkmcnt(0)
s_barrier
ds_read_b128 v[104:107], v8 offset:50448
ds_read_b128 v[108:111], v8 offset:50512
ds_read_b128 v[112:115], v8 offset:50576
ds_read_b128 v[116:119], v8 offset:50640
s_waitcnt lgkmcnt(3)
v_mfma_f32_16x16x32_bf16 v[100:103], v[72:75], v[104:107], 0
s_waitcnt lgkmcnt(2)
v_mfma_f32_16x16x32_bf16 v[100:103], v[76:79], v[108:111], v[100:103]
s_waitcnt lgkmcnt(1)
v_mfma_f32_16x16x32_bf16 v[100:103], v[80:83], v[112:115], v[100:103]
s_waitcnt lgkmcnt(0)
v_mfma_f32_16x16x32_bf16 v[100:103], v[84:87], v[116:119], v[100:103]
s_mov_b64 exec, vcc
s_nop 6
v_fma_f32 v100, v100, v12, v96
v_fma_f32 v101, v101, v12, v97
v_fma_f32 v102, v102, v12, v98
v_fma_f32 v103, v103, v12, v99
v_min_u32 v100, s67, v100
v_min_u32 v101, s67, v101
v_min_u32 v102, s67, v102
v_min_u32 v103, s67, v103
buffer_store_dwordx4 v[100:103], v6, s[44:47], s62 offen sc1
s_endpgm
L_vpath:
s_waitcnt lgkmcnt(0)
s_mov_b32 s44, s32
s_mov_b32 s45, s33
s_mov_b32 s46, 0x200000
s_mov_b32 s47, 0x20000
s_cmp_eq_u32 s3, 6
s_cbranch_scc1 L_v2
s_cmp_eq_u32 s3, 7
s_cbranch_scc1 L_v3
s_cmp_eq_u32 s3, 5
s_cbranch_scc1 L_v1
s_mov_b32 s52, s14
s_mov_b32 s53, s15
s_mov_b32 s54, 0x400000
s_mov_b32 s55, 0x20000
s_lshr_b32 s66, s35, 2
s_and_b32 s68, s35, 3
s_lshl_b32 s62, s34, 10
s_lshl_b32 s63, s66, 7
s_add_u32 s62, s62, s63
s_lshl_b32 s63, s68, 20
s_add_u32 s62, s62, s63
s_movk_i32 s73, 8192
s_mov_b32 s67, 0
s_mov_b32 s74, 65536
s_lshl_b32 s75, s34, 13
s_lshr_b32 s63, s66, 1
s_lshl_b32 s63, s63, 11
s_add_u32 s75, s75, s63
s_lshl_b32 s63, s68, 9
s_add_u32 s75, s75, s63
s_and_b32 s63, s66, 1
s_lshl_b32 s63, s63, 8
s_add_u32 s75, s75, s63
s_add_u32 s75, s75, 0
s_branch L_tile
L_v1:
s_cmp_ge_u32 s2, 224
s_cbranch_scc1 L_b0arr
s_lshr_b32 s66, s2, 3
s_bfe_u32 s68, s2, 0x20001
s_and_b32 s69, s2, 1
s_cmp_eq_u32 s69, 0
s_cselect_b32 s52, s20, s22
s_cselect_b32 s53, s21, s23
s_mov_b32 s54, 1835008
s_mov_b32 s55, 0x20000
s_lshl_b32 s62, s66, 7
s_mul_i32 s63, s68, 458752
s_add_u32 s62, s62, s63
s_movk_i32 s73, 3584
s_mov_b32 s67, 16384
s_movk_i32 s74, 2048
s_lshl_b32 s75, s66, 13
s_lshl_b32 s63, s69, 2
s_add_u32 s63, s63, s68
s_lshl_b32 s63, s63, 8
s_add_u32 s75, s75, s63
s_add_u32 s75, s75, 262144
L_tile:
s_mov_b32 s48, s8
s_mov_b32 s49, s9
s_mov_b32 s50, 0x1000
s_mov_b32 s51, 0x20000
v_and_b32 v5, 3, v3
v_lshlrev_b32 v5, 10, v5
v_lshlrev_b32 v6, 4, v2
v_add_u32 v5, v5, v6
s_lshl_b32 s69, s68, 8
v_lshrrev_b32 v4, 3, v1
v_mul_u32_u24 v4, s73, v4
v_and_b32 v6, 7, v1
v_lshlrev_b32 v6, 4, v6
v_add_u32 v4, v4, v6
buffer_load_dwordx4 v[64:67], v5, s[48:51], s69 offen offset:0
buffer_load_dwordx4 v[68:71], v5, s[48:51], s69 offen offset:64
buffer_load_dwordx4 v[72:75], v5, s[48:51], s69 offen offset:128
buffer_load_dwordx4 v[76:79], v5, s[48:51], s69 offen offset:192
s_lshl_b32 s72, s73, 3
s_mov_b32 s76, s67
s_movk_i32 s77, 16
L_dma:
s_mov_b32 m0, s76
s_add_u32 s76, s76, 1024
buffer_load_dwordx4 v4, s[52:55], s62 offen nt lds
s_add_u32 s62, s62, s72
s_sub_u32 s77, s77, 1
s_cmp_lg_u32 s77, 0
s_cbranch_scc1 L_dma
L_dma_end:
s_barrier
v_lshrrev_b32 v7, 2, v3
v_lshlrev_b32 v8, 3, v2
v_add_u32 v7, v7, v8
v_lshlrev_b32 v7, 7, v7
v_and_b32 v8, 3, v3
v_lshlrev_b32 v8, 3, v8
v_add_u32 v7, v7, v8
v_add_u32 v7, s67, v7
v_mul_u32_u24 v9, s74, v3
v_lshlrev_b32 v10, 4, v2
v_add_u32 v9, v9, v10
s_waitcnt vmcnt(0)
ds_read_b64_tr_b16 v[128:129], v7 offset:0
ds_read_b64_tr_b16 v[130:131], v7 offset:512
ds_read_b64_tr_b16 v[132:133], v7 offset:4096
ds_read_b64_tr_b16 v[134:135], v7 offset:4608
ds_read_b64_tr_b16 v[136:137], v7 offset:8192
ds_read_b64_tr_b16 v[138:139], v7 offset:8704
ds_read_b64_tr_b16 v[140:141], v7 offset:12288
ds_read_b64_tr_b16 v[142:143], v7 offset:12800
ds_read_b64_tr_b16 v[144:145], v7 offset:32
ds_read_b64_tr_b16 v[146:147], v7 offset:544
ds_read_b64_tr_b16 v[148:149], v7 offset:4128
ds_read_b64_tr_b16 v[150:151], v7 offset:4640
ds_read_b64_tr_b16 v[152:153], v7 offset:8224
ds_read_b64_tr_b16 v[154:155], v7 offset:8736
ds_read_b64_tr_b16 v[156:157], v7 offset:12320
ds_read_b64_tr_b16 v[158:159], v7 offset:12832
ds_read_b64_tr_b16 v[160:161], v7 offset:64
ds_read_b64_tr_b16 v[162:163], v7 offset:576
ds_read_b64_tr_b16 v[164:165], v7 offset:4160
ds_read_b64_tr_b16 v[166:167], v7 offset:4672
ds_read_b64_tr_b16 v[168:169], v7 offset:8256
ds_read_b64_tr_b16 v[170:171], v7 offset:8768
ds_read_b64_tr_b16 v[172:173], v7 offset:12352
ds_read_b64_tr_b16 v[174:175], v7 offset:12864
ds_read_b64_tr_b16 v[176:177], v7 offset:96
ds_read_b64_tr_b16 v[178:179], v7 offset:608
ds_read_b64_tr_b16 v[180:181], v7 offset:4192
ds_read_b64_tr_b16 v[182:183], v7 offset:4704
ds_read_b64_tr_b16 v[184:185], v7 offset:8288
ds_read_b64_tr_b16 v[186:187], v7 offset:8800
ds_read_b64_tr_b16 v[188:189], v7 offset:12384
ds_read_b64_tr_b16 v[190:191], v7 offset:12896
s_waitcnt lgkmcnt(0)
v_mfma_f32_16x16x32_bf16 v[16:19], v[128:131], v[64:67], 0
v_mfma_f32_16x16x32_bf16 v[20:23], v[144:147], v[64:67], 0
v_mfma_f32_16x16x32_bf16 v[24:27], v[160:163], v[64:67], 0
v_mfma_f32_16x16x32_bf16 v[28:31], v[176:179], v[64:67], 0
v_mfma_f32_16x16x32_bf16 v[16:19], v[132:135], v[68:71], v[16:19]
v_mfma_f32_16x16x32_bf16 v[20:23], v[148:151], v[68:71], v[20:23]
v_mfma_f32_16x16x32_bf16 v[24:27], v[164:167], v[68:71], v[24:27]
v_mfma_f32_16x16x32_bf16 v[28:31], v[180:183], v[68:71], v[28:31]
v_mfma_f32_16x16x32_bf16 v[16:19], v[136:139], v[72:75], v[16:19]
v_mfma_f32_16x16x32_bf16 v[20:23], v[152:155], v[72:75], v[20:23]
v_mfma_f32_16x16x32_bf16 v[24:27], v[168:171], v[72:75], v[24:27]
v_mfma_f32_16x16x32_bf16 v[28:31], v[184:187], v[72:75], v[28:31]
v_mfma_f32_16x16x32_bf16 v[16:19], v[140:143], v[76:79], v[16:19]
v_mfma_f32_16x16x32_bf16 v[20:23], v[156:159], v[76:79], v[20:23]
v_mfma_f32_16x16x32_bf16 v[24:27], v[172:175], v[76:79], v[24:27]
v_mfma_f32_16x16x32_bf16 v[28:31], v[188:191], v[76:79], v[28:31]
v_cmp_gt_u32 vcc, 4, v3
s_and_saveexec_b64 s[64:65], vcc
s_nop 7
buffer_store_dwordx4 v[16:19], v9, s[44:47], s75 offen offset:0 sc1
buffer_store_dwordx4 v[20:23], v9, s[44:47], s75 offen offset:64 sc1
buffer_store_dwordx4 v[24:27], v9, s[44:47], s75 offen offset:128 sc1
buffer_store_dwordx4 v[28:31], v9, s[44:47], s75 offen offset:192 sc1
s_mov_b64 exec, s[64:65]
s_branch L_arrive
L_v2:
s_barrier
s_mov_b32 s52, s26
s_mov_b32 s53, s27
s_mov_b32 s54, 0x400
s_mov_b32 s55, 0x20000
s_mov_b32 s48, s8
s_mov_b32 s49, s9
s_mov_b32 s50, 0x1000
s_mov_b32 s51, 0x20000
v_lshlrev_b32 v6, 4, v1
buffer_load_dwordx4 v[64:67], v6, s[48:51], 0 offen offset:0
buffer_load_dwordx4 v[68:71], v6, s[48:51], 0 offen offset:1024
buffer_load_dwordx4 v[72:75], v6, s[48:51], 0 offen offset:2048
buffer_load_dwordx4 v[76:79], v6, s[48:51], 0 offen offset:3072
buffer_load_dwordx4 v[80:83], v6, s[52:55], 0 offen
s_lshl_b32 s62, s37, 15
s_lshl_b32 s67, s38, 10
s_add_u32 s62, s62, s67
s_add_u32 s62, s62, 1048576
v_mov_b32 v8, -1
v_mov_b32 v9, -1
v_mov_b32 v10, -1
v_mov_b32 v11, -1
buffer_store_dwordx4 v[8:11], v6, s[44:47], s62 offen sc1
v_mov_b32 v16, 0
v_mov_b32 v17, 0
v_mov_b32 v18, 0
v_mov_b32 v19, 0
s_waitcnt vmcnt(0)
v_dot2_f32_bf16 v16, v64, v80, v16
v_dot2_f32_bf16 v17, v68, v80, v17
v_dot2_f32_bf16 v18, v72, v80, v18
v_dot2_f32_bf16 v19, v76, v80, v19
v_dot2_f32_bf16 v16, v65, v81, v16
v_dot2_f32_bf16 v17, v69, v81, v17
v_dot2_f32_bf16 v18, v73, v81, v18
v_dot2_f32_bf16 v19, v77, v81, v19
v_dot2_f32_bf16 v16, v66, v82, v16
v_dot2_f32_bf16 v17, v70, v82, v17
v_dot2_f32_bf16 v18, v74, v82, v18
v_dot2_f32_bf16 v19, v78, v82, v19
v_dot2_f32_bf16 v16, v67, v83, v16
v_dot2_f32_bf16 v17, v71, v83, v17
v_dot2_f32_bf16 v18, v75, v83, v18
v_dot2_f32_bf16 v19, v79, v83, v19
s_nop 3
v_add_f32_dpp v16, v16, v16 row_ror:8 row_mask:0xf bank_mask:0xf
v_add_f32_dpp v17, v17, v17 row_ror:8 row_mask:0xf bank_mask:0xf
v_add_f32_dpp v18, v18, v18 row_ror:8 row_mask:0xf bank_mask:0xf
v_add_f32_dpp v19, v19, v19 row_ror:8 row_mask:0xf bank_mask:0xf
v_add_f32_dpp v16, v16, v16 row_ror:4 row_mask:0xf bank_mask:0xf
v_add_f32_dpp v17, v17, v17 row_ror:4 row_mask:0xf bank_mask:0xf
v_add_f32_dpp v18, v18, v18 row_ror:4 row_mask:0xf bank_mask:0xf
v_add_f32_dpp v19, v19, v19 row_ror:4 row_mask:0xf bank_mask:0xf
v_add_f32_dpp v16, v16, v16 row_ror:2 row_mask:0xf bank_mask:0xf
v_add_f32_dpp v17, v17, v17 row_ror:2 row_mask:0xf bank_mask:0xf
v_add_f32_dpp v18, v18, v18 row_ror:2 row_mask:0xf bank_mask:0xf
v_add_f32_dpp v19, v19, v19 row_ror:2 row_mask:0xf bank_mask:0xf
v_add_f32_dpp v16, v16, v16 row_ror:1 row_mask:0xf bank_mask:0xf
v_add_f32_dpp v17, v17, v17 row_ror:1 row_mask:0xf bank_mask:0xf
v_add_f32_dpp v18, v18, v18 row_ror:1 row_mask:0xf bank_mask:0xf
v_add_f32_dpp v19, v19, v19 row_ror:1 row_mask:0xf bank_mask:0xf
v_mov_b32 v20, v16
v_mov_b32 v21, v17
v_mov_b32 v22, v18
v_mov_b32 v23, v19
s_nop 1
v_permlane16_swap_b32 v16, v20
v_permlane16_swap_b32 v17, v21
v_permlane16_swap_b32 v18, v22
v_permlane16_swap_b32 v19, v23
s_nop 1
v_add_f32 v16, v16, v20
v_add_f32 v17, v17, v21
v_add_f32 v18, v18, v22
v_add_f32 v19, v19, v23
v_mov_b32 v20, v16
v_mov_b32 v21, v17
v_mov_b32 v22, v18
v_mov_b32 v23, v19
s_nop 1
v_permlane32_swap_b32 v16, v20
v_permlane32_swap_b32 v17, v21
v_permlane32_swap_b32 v18, v22
v_permlane32_swap_b32 v19, v23
s_nop 1
v_add_f32 v16, v16, v20
v_add_f32 v17, v17, v21
v_add_f32 v18, v18, v22
v_add_f32 v19, v19, v23
v_mul_f32 v28, 0xbfb8aa3b, v16
v_exp_f32 v28, v28
s_nop 0
v_add_f32 v28, 1.0, v28
v_rcp_f32 v24, v28
s_nop 0
v_mul_f32 v29, 0xbfb8aa3b, v17
v_exp_f32 v29, v29
s_nop 0
v_add_f32 v29, 1.0, v29
v_rcp_f32 v25, v29
s_nop 0
v_mul_f32 v30, 0xbfb8aa3b, v18
v_exp_f32 v30, v30
s_nop 0
v_add_f32 v30, 1.0, v30
v_rcp_f32 v26, v30
s_nop 0
v_mul_f32 v31, 0xbfb8aa3b, v19
v_exp_f32 v31, v31
s_nop 0
v_add_f32 v31, 1.0, v31
v_rcp_f32 v27, v31
s_nop 0
v_mov_b32 v6, 42112
s_mov_b64 exec, 1
ds_write_b128 v6, v[24:27]
s_mov_b64 exec, -1
s_branch L_arrive
L_b0arr:
s_barrier
s_branch L_arrive
L_v3:
s_barrier
v_lshrrev_b32 v6, 5, v1
v_lshlrev_b32 v6, 14, v6
v_and_b32 v7, 31, v1
v_lshlrev_b32 v7, 4, v7
v_add_u32 v6, v6, v7
s_lshl_b32 s62, s34, 16
s_lshl_b32 s63, s36, 12
s_add_u32 s62, s62, s63
s_lshl_b32 s63, s37, 9
s_add_u32 s62, s62, s63
s_add_u32 s62, s62, 524288
v_mov_b32 v8, -1
v_mov_b32 v9, -1
v_mov_b32 v10, -1
v_mov_b32 v11, -1
buffer_store_dwordx4 v[8:11], v6, s[44:47], s62 offen sc1
s_add_u32 s62, s62, 32768
buffer_store_dwordx4 v[8:11], v6, s[44:47], s62 offen sc1
v_lshlrev_b32 v5, 8, v2
s_lshl_b32 s62, s34, 10
s_lshl_b32 s63, s36, 6
s_add_u32 s62, s62, s63
s_lshl_b32 s63, s37, 3
s_add_u32 s62, s62, s63
s_add_u32 s62, s62, 491520
v_cmp_eq_u32 vcc, 0, v3
s_and_saveexec_b64 s[64:65], vcc
buffer_store_dwordx2 v[8:9], v5, s[44:47], s62 offen sc1
s_mov_b64 exec, s[64:65]
L_arrive:
s_waitcnt vmcnt(0)
v_mov_b32 v4, 42128
v_mov_b32 v5, 1
s_mov_b64 exec, 1
ds_add_rtn_u32 v6, v4, v5
s_mov_b32 s56, s30
s_mov_b32 s57, s31
s_mov_b32 s58, 0x100
s_mov_b32 s59, 0x20000
s_getreg_b32 s66, hwreg(HW_REG_XCC_ID, 0, 4)
s_mul_i32 s67, s66, s66
s_lshl_b32 s67, s67, 14
s_lshl_b32 s66, s66, 6
s_add_u32 s66, s66, s67
s_add_u32 s66, s66, 1
s_lshl_b32 s62, s34, 5
v_mov_b32 v4, s62
v_mov_b32 v5, s66
s_waitcnt lgkmcnt(0)
v_cmp_eq_u32 vcc, 3, v6
s_cbranch_vccz L_nosig
buffer_atomic_add v5, v4, s[56:59], 0 offen
L_nosig:
s_mov_b64 exec, -1
s_mov_b32 s40, s12
s_mov_b32 s41, s13
s_mov_b32 s42, 0x2000000
s_mov_b32 s43, 0x20000
v_lshlrev_b32 v4, 4, v1
v_and_b32 v5, 3, v1
v_and_b32 v6, 1, v1
v_mov_b32 v7, 0xffff
v_lshlrev_b32 v6, 4, v6
v_lshlrev_b32 v7, v6, v7
v_cmp_gt_u32 vcc, 2, v5
s_nop 1
v_cndmask_b32 v8, 0, v7, vcc
v_sub_u32 v9, v7, v8
v_lshrrev_b32 v10, 2, v3
v_lshlrev_b32 v10, 2, v10
v_add_u32 v10, v10, v2
v_mul_u32_u24 v10, 144, v10
s_mul_i32 s62, s39, 2304
s_add_u32 s62, s62, 32768
v_add_u32 v10, s62, v10
s_barrier
s_add_u32 s62, s60, 0
buffer_load_dwordx4 v[64:67], v4, s[40:43], s62 offen offset:0 nt
buffer_load_dwordx4 v[68:71], v4, s[40:43], s62 offen offset:1024 nt
buffer_load_dwordx4 v[72:75], v4, s[40:43], s62 offen offset:2048 nt
buffer_load_dwordx4 v[76:79], v4, s[40:43], s62 offen offset:3072 nt
s_add_u32 s62, s60, 4096
buffer_load_dwordx4 v[80:83], v4, s[40:43], s62 offen offset:0 nt
s_waitcnt vmcnt(4)
buffer_load_dwordx4 v[84:87], v4, s[40:43], s62 offen offset:1024 nt
s_waitcnt vmcnt(4)
buffer_load_dwordx4 v[88:91], v4, s[40:43], s62 offen offset:2048 nt
s_waitcnt vmcnt(4)
buffer_load_dwordx4 v[92:95], v4, s[40:43], s62 offen offset:3072 nt
s_waitcnt vmcnt(4)
s_add_u32 s62, s60, 32768
buffer_load_dwordx4 v[96:99], v4, s[40:43], s62 offen offset:0 nt
s_waitcnt vmcnt(4)
buffer_load_dwordx4 v[100:103], v4, s[40:43], s62 offen offset:1024 nt
s_waitcnt vmcnt(4)
buffer_load_dwordx4 v[104:107], v4, s[40:43], s62 offen offset:2048 nt
s_waitcnt vmcnt(4)
buffer_load_dwordx4 v[108:111], v4, s[40:43], s62 offen offset:3072 nt
s_waitcnt vmcnt(4)
s_add_u32 s62, s60, 36864
buffer_load_dwordx4 v[112:115], v4, s[40:43], s62 offen offset:0 nt
s_waitcnt vmcnt(4)
buffer_load_dwordx4 v[116:119], v4, s[40:43], s62 offen offset:1024 nt
s_waitcnt vmcnt(4)
buffer_load_dwordx4 v[120:123], v4, s[40:43], s62 offen offset:2048 nt
s_waitcnt vmcnt(4)
buffer_load_dwordx4 v[124:127], v4, s[40:43], s62 offen offset:3072 nt
s_waitcnt vmcnt(4)
s_add_u32 s62, s60, 65536
buffer_load_dwordx4 v[128:131], v4, s[40:43], s62 offen offset:0 nt
s_waitcnt vmcnt(4)
buffer_load_dwordx4 v[132:135], v4, s[40:43], s62 offen offset:1024 nt
s_waitcnt vmcnt(4)
buffer_load_dwordx4 v[136:139], v4, s[40:43], s62 offen offset:2048 nt
s_waitcnt vmcnt(4)
buffer_load_dwordx4 v[140:143], v4, s[40:43], s62 offen offset:3072 nt
s_add_u32 s62, s60, 69632
buffer_load_dwordx4 v[144:147], v4, s[40:43], s62 offen offset:0 nt
buffer_load_dwordx4 v[148:151], v4, s[40:43], s62 offen offset:1024 nt
buffer_load_dwordx4 v[152:155], v4, s[40:43], s62 offen offset:2048 nt
buffer_load_dwordx4 v[156:159], v4, s[40:43], s62 offen offset:3072 nt
s_add_u32 s62, s60, 98304
buffer_load_dwordx4 v[160:163], v4, s[40:43], s62 offen offset:0 nt
buffer_load_dwordx4 v[164:167], v4, s[40:43], s62 offen offset:1024 nt
buffer_load_dwordx4 v[168:171], v4, s[40:43], s62 offen offset:2048 nt
buffer_load_dwordx4 v[172:175], v4, s[40:43], s62 offen offset:3072 nt
s_add_u32 s62, s60, 102400
buffer_load_dwordx4 v[176:179], v4, s[40:43], s62 offen offset:0 nt
buffer_load_dwordx4 v[180:183], v4, s[40:43], s62 offen offset:1024 nt
buffer_load_dwordx4 v[184:187], v4, s[40:43], s62 offen offset:2048 nt
buffer_load_dwordx4 v[188:191], v4, s[40:43], s62 offen offset:3072 nt
s_barrier
ds_read_b128 v[16:19], v10 offset:0
ds_read_b128 v[20:23], v10 offset:16
ds_read_b128 v[24:27], v10 offset:32
ds_read_b128 v[28:31], v10 offset:48
ds_read_b128 v[32:35], v10 offset:64
ds_read_b128 v[36:39], v10 offset:80
ds_read_b128 v[40:43], v10 offset:96
ds_read_b128 v[44:47], v10 offset:112
s_lshl_b32 s62, s39, 5
v_mov_b32 v11, s62
ds_read_b128 v[192:195], v11 offset:41984
ds_read_b128 v[196:199], v11 offset:42000
v_mov_b32 v12, 42148
ds_read_b32 v13, v12
s_waitcnt lgkmcnt(0)
v_readfirstlane_b32 s71, v13
v_and_b32 v48, v16, v8
v_and_b32 v49, v16, v9
v_and_b32 v50, v17, v8
v_and_b32 v51, v17, v9
v_and_b32 v52, v18, v8
v_and_b32 v53, v18, v9
s_waitcnt vmcnt(31)
v_mfma_f32_16x16x16_bf16 v[56:59], v[48:49], v[64:65], 0
v_mfma_f32_16x16x16_bf16 v[60:63], v[48:49], v[66:67], 0
v_and_b32 v54, v19, v8
v_and_b32 v55, v19, v9
s_waitcnt vmcnt(30)
v_mfma_f32_16x16x16_bf16 v[56:59], v[50:51], v[68:69], v[56:59]
v_mfma_f32_16x16x16_bf16 v[60:63], v[50:51], v[70:71], v[60:63]
v_and_b32 v48, v20, v8
v_and_b32 v49, v20, v9
s_waitcnt vmcnt(29)
v_mfma_f32_16x16x16_bf16 v[56:59], v[52:53], v[72:73], v[56:59]
v_mfma_f32_16x16x16_bf16 v[60:63], v[52:53], v[74:75], v[60:63]
v_and_b32 v50, v21, v8
v_and_b32 v51, v21, v9
s_waitcnt vmcnt(28)
v_mfma_f32_16x16x16_bf16 v[56:59], v[54:55], v[76:77], v[56:59]
v_mfma_f32_16x16x16_bf16 v[60:63], v[54:55], v[78:79], v[60:63]
v_and_b32 v52, v22, v8
v_and_b32 v53, v22, v9
s_waitcnt vmcnt(27)
v_mfma_f32_16x16x16_bf16 v[56:59], v[48:49], v[80:81], v[56:59]
v_mfma_f32_16x16x16_bf16 v[60:63], v[48:49], v[82:83], v[60:63]
v_and_b32 v54, v23, v8
v_and_b32 v55, v23, v9
s_waitcnt vmcnt(26)
v_mfma_f32_16x16x16_bf16 v[56:59], v[50:51], v[84:85], v[56:59]
v_mfma_f32_16x16x16_bf16 v[60:63], v[50:51], v[86:87], v[60:63]
v_and_b32 v48, v24, v8
v_and_b32 v49, v24, v9
s_waitcnt vmcnt(25)
v_mfma_f32_16x16x16_bf16 v[56:59], v[52:53], v[88:89], v[56:59]
v_mfma_f32_16x16x16_bf16 v[60:63], v[52:53], v[90:91], v[60:63]
v_and_b32 v50, v25, v8
v_and_b32 v51, v25, v9
s_waitcnt vmcnt(24)
v_mfma_f32_16x16x16_bf16 v[56:59], v[54:55], v[92:93], v[56:59]
v_mfma_f32_16x16x16_bf16 v[60:63], v[54:55], v[94:95], v[60:63]
v_max3_f32 v201, v192, v194, v196
v_max_f32 v201, v201, v198
v_sub_f32 v192, v192, v201
v_sub_f32 v194, v194, v201
v_sub_f32 v196, v196, v201
v_sub_f32 v198, v198, v201
v_exp_f32 v192, v192
v_exp_f32 v194, v194
v_exp_f32 v196, v196
v_exp_f32 v198, v198
v_lshlrev_b32 v11, 9, v2
v_lshlrev_b32 v12, 5, v3
v_add_u32 v11, v11, v12
s_lshl_b32 s62, s39, 11
s_add_u32 s62, s62, 42256
v_add_u32 v11, s62, v11
v_lshlrev_b32 v12, 3, v1
s_lshl_b32 s62, s39, 9
s_add_u32 s62, s62, 42256
v_add_u32 v12, s62, v12
s_lshl_b32 s62, s34, 16
s_lshl_b32 s63, s39, 14
s_add_u32 s62, s62, s63
s_lshl_b32 s63, s36, 12
s_add_u32 s62, s62, s63
s_lshl_b32 s63, s37, 9
s_add_u32 s62, s62, s63
s_add_u32 s62, s62, 524288
v_lshlrev_b32 v13, 3, v1
s_mov_b32 s67, 0xfffffffe
v_and_b32 v52, v26, v8
v_and_b32 v53, v26, v9
s_waitcnt vmcnt(23)
v_mfma_f32_16x16x16_bf16 v[56:59], v[48:49], v[96:97], v[56:59]
v_mfma_f32_16x16x16_bf16 v[60:63], v[48:49], v[98:99], v[60:63]
v_and_b32 v54, v27, v8
v_and_b32 v55, v27, v9
s_waitcnt vmcnt(22)
v_mfma_f32_16x16x16_bf16 v[56:59], v[50:51], v[100:101], v[56:59]
v_mfma_f32_16x16x16_bf16 v[60:63], v[50:51], v[102:103], v[60:63]
v_and_b32 v48, v28, v8
v_and_b32 v49, v28, v9
s_waitcnt vmcnt(21)
v_mfma_f32_16x16x16_bf16 v[56:59], v[52:53], v[104:105], v[56:59]
v_mfma_f32_16x16x16_bf16 v[60:63], v[52:53], v[106:107], v[60:63]
v_and_b32 v50, v29, v8
v_and_b32 v51, v29, v9
s_waitcnt vmcnt(20)
v_mfma_f32_16x16x16_bf16 v[56:59], v[54:55], v[108:109], v[56:59]
v_mfma_f32_16x16x16_bf16 v[60:63], v[54:55], v[110:111], v[60:63]
v_and_b32 v52, v30, v8
v_and_b32 v53, v30, v9
s_waitcnt vmcnt(19)
v_mfma_f32_16x16x16_bf16 v[56:59], v[48:49], v[112:113], v[56:59]
v_mfma_f32_16x16x16_bf16 v[60:63], v[48:49], v[114:115], v[60:63]
v_and_b32 v54, v31, v8
v_and_b32 v55, v31, v9
s_waitcnt vmcnt(18)
v_mfma_f32_16x16x16_bf16 v[56:59], v[50:51], v[116:117], v[56:59]
v_mfma_f32_16x16x16_bf16 v[60:63], v[50:51], v[118:119], v[60:63]
v_and_b32 v48, v32, v8
v_and_b32 v49, v32, v9
s_waitcnt vmcnt(17)
v_mfma_f32_16x16x16_bf16 v[56:59], v[52:53], v[120:121], v[56:59]
v_mfma_f32_16x16x16_bf16 v[60:63], v[52:53], v[122:123], v[60:63]
v_and_b32 v50, v33, v8
v_and_b32 v51, v33, v9
s_waitcnt vmcnt(16)
v_mfma_f32_16x16x16_bf16 v[56:59], v[54:55], v[124:125], v[56:59]
v_mfma_f32_16x16x16_bf16 v[60:63], v[54:55], v[126:127], v[60:63]
v_and_b32 v52, v34, v8
v_and_b32 v53, v34, v9
s_waitcnt vmcnt(15)
v_mfma_f32_16x16x16_bf16 v[56:59], v[48:49], v[128:129], v[56:59]
v_mfma_f32_16x16x16_bf16 v[60:63], v[48:49], v[130:131], v[60:63]
v_and_b32 v54, v35, v8
v_and_b32 v55, v35, v9
s_waitcnt vmcnt(14)
v_mfma_f32_16x16x16_bf16 v[56:59], v[50:51], v[132:133], v[56:59]
v_mfma_f32_16x16x16_bf16 v[60:63], v[50:51], v[134:135], v[60:63]
v_and_b32 v48, v36, v8
v_and_b32 v49, v36, v9
s_waitcnt vmcnt(13)
v_mfma_f32_16x16x16_bf16 v[56:59], v[52:53], v[136:137], v[56:59]
v_mfma_f32_16x16x16_bf16 v[60:63], v[52:53], v[138:139], v[60:63]
v_and_b32 v50, v37, v8
v_and_b32 v51, v37, v9
s_waitcnt vmcnt(12)
v_mfma_f32_16x16x16_bf16 v[56:59], v[54:55], v[140:141], v[56:59]
v_mfma_f32_16x16x16_bf16 v[60:63], v[54:55], v[142:143], v[60:63]
v_and_b32 v52, v38, v8
v_and_b32 v53, v38, v9
s_waitcnt vmcnt(11)
v_mfma_f32_16x16x16_bf16 v[56:59], v[48:49], v[144:145], v[56:59]
v_mfma_f32_16x16x16_bf16 v[60:63], v[48:49], v[146:147], v[60:63]
v_and_b32 v54, v39, v8
v_and_b32 v55, v39, v9
s_waitcnt vmcnt(10)
v_mfma_f32_16x16x16_bf16 v[56:59], v[50:51], v[148:149], v[56:59]
v_mfma_f32_16x16x16_bf16 v[60:63], v[50:51], v[150:151], v[60:63]
v_and_b32 v48, v40, v8
v_and_b32 v49, v40, v9
s_waitcnt vmcnt(9)
v_mfma_f32_16x16x16_bf16 v[56:59], v[52:53], v[152:153], v[56:59]
v_mfma_f32_16x16x16_bf16 v[60:63], v[52:53], v[154:155], v[60:63]
v_and_b32 v50, v41, v8
v_and_b32 v51, v41, v9
s_waitcnt vmcnt(8)
v_mfma_f32_16x16x16_bf16 v[56:59], v[54:55], v[156:157], v[56:59]
v_mfma_f32_16x16x16_bf16 v[60:63], v[54:55], v[158:159], v[60:63]
v_and_b32 v52, v42, v8
v_and_b32 v53, v42, v9
s_waitcnt vmcnt(7)
v_mfma_f32_16x16x16_bf16 v[56:59], v[48:49], v[160:161], v[56:59]
v_mfma_f32_16x16x16_bf16 v[60:63], v[48:49], v[162:163], v[60:63]
v_and_b32 v54, v43, v8
v_and_b32 v55, v43, v9
s_waitcnt vmcnt(6)
v_mfma_f32_16x16x16_bf16 v[56:59], v[50:51], v[164:165], v[56:59]
v_mfma_f32_16x16x16_bf16 v[60:63], v[50:51], v[166:167], v[60:63]
v_and_b32 v48, v44, v8
v_and_b32 v49, v44, v9
s_waitcnt vmcnt(5)
v_mfma_f32_16x16x16_bf16 v[56:59], v[52:53], v[168:169], v[56:59]
v_mfma_f32_16x16x16_bf16 v[60:63], v[52:53], v[170:171], v[60:63]
v_and_b32 v50, v45, v8
v_and_b32 v51, v45, v9
s_waitcnt vmcnt(4)
v_mfma_f32_16x16x16_bf16 v[56:59], v[54:55], v[172:173], v[56:59]
v_mfma_f32_16x16x16_bf16 v[60:63], v[54:55], v[174:175], v[60:63]
v_and_b32 v52, v46, v8
v_and_b32 v53, v46, v9
s_waitcnt vmcnt(3)
v_mfma_f32_16x16x16_bf16 v[56:59], v[48:49], v[176:177], v[56:59]
v_mfma_f32_16x16x16_bf16 v[60:63], v[48:49], v[178:179], v[60:63]
v_and_b32 v54, v47, v8
v_and_b32 v55, v47, v9
s_waitcnt vmcnt(2)
v_mfma_f32_16x16x16_bf16 v[56:59], v[50:51], v[180:181], v[56:59]
v_mfma_f32_16x16x16_bf16 v[60:63], v[50:51], v[182:183], v[60:63]
s_nop 0
s_waitcnt vmcnt(1)
v_mfma_f32_16x16x16_bf16 v[56:59], v[52:53], v[184:185], v[56:59]
v_mfma_f32_16x16x16_bf16 v[60:63], v[52:53], v[186:187], v[60:63]
s_nop 0
s_waitcnt vmcnt(0)
v_mfma_f32_16x16x16_bf16 v[56:59], v[54:55], v[188:189], v[56:59]
v_mfma_f32_16x16x16_bf16 v[60:63], v[54:55], v[190:191], v[60:63]
s_nop 6
ds_write_b128 v11, v[56:59]
ds_write_b128 v11, v[60:63] offset:16
s_waitcnt lgkmcnt(0)
s_barrier
ds_read_b64 v[16:17], v12 offset:0
ds_read_b64 v[18:19], v12 offset:2048
ds_read_b64 v[20:21], v12 offset:4096
ds_read_b64 v[22:23], v12 offset:6144
s_waitcnt lgkmcnt(0)
v_mul_f32 v16, v192, v16
v_mul_f32 v17, v192, v17
v_mul_f32 v20, v196, v20
v_mul_f32 v21, v196, v21
v_fmac_f32 v16, v194, v18
v_fmac_f32 v17, v194, v19
v_fmac_f32 v20, v198, v22
v_fmac_f32 v21, v198, v23
v_add_f32 v16, v16, v20
v_add_f32 v17, v17, v21
v_min_u32 v16, s67, v16
v_min_u32 v17, s67, v17
s_cmp_eq_u32 s71, 1
s_cbranch_scc1 L_ms5
buffer_store_dwordx2 v[16:17], v13, s[44:47], s62 offen sc1
s_branch L_msd5
L_ms5:
buffer_store_dwordx2 v[16:17], v13, s[44:47], s62 offen
L_msd5:
s_cmp_eq_u32 s3, 4
s_cbranch_scc1 L_final
s_endpgm
L_final:
s_mov_b32 s48, s28
s_mov_b32 s49, s29
s_mov_b32 s50, 0x1000
s_mov_b32 s51, 0x20000
v_lshlrev_b32 v4, 2, v1
s_lshr_b32 s63, s38, 3
s_and_b32 s66, s38, 7
s_lshl_b32 s62, s37, 15
s_lshl_b32 s67, s38, 10
s_add_u32 s62, s62, s67
s_add_u32 s62, s62, 1048576
s_lshl_b32 s63, s63, 10
s_lshl_b32 s67, s37, 7
s_add_u32 s63, s63, s67
s_lshl_b32 s67, s66, 4
s_add_u32 s66, s63, s67
v_lshlrev_b32 v5, 1, v1
s_barrier
s_mov_b32 s63, 65536
buffer_load_dword v16, v4, s[44:47], s62 offen offset:0 sc1
buffer_load_dword v17, v4, s[44:47], s62 offen offset:256 sc1
buffer_load_dword v18, v4, s[44:47], s62 offen offset:512 sc1
buffer_load_dword v19, v4, s[44:47], s62 offen offset:768 sc1
L_fpoll:
buffer_load_dword v20, v4, s[44:47], s62 offen offset:0 sc1
buffer_load_dword v21, v4, s[44:47], s62 offen offset:256 sc1
buffer_load_dword v22, v4, s[44:47], s62 offen offset:512 sc1
buffer_load_dword v23, v4, s[44:47], s62 offen offset:768 sc1
s_waitcnt vmcnt(4)
v_max3_u32 v12, v16, v17, v18
v_max_u32 v12, v12, v19
v_cmp_eq_u32 vcc, -1, v12
s_cbranch_vccz L_fA
buffer_load_dword v16, v4, s[44:47], s62 offen offset:0 sc1
buffer_load_dword v17, v4, s[44:47], s62 offen offset:256 sc1
buffer_load_dword v18, v4, s[44:47], s62 offen offset:512 sc1
buffer_load_dword v19, v4, s[44:47], s62 offen offset:768 sc1
s_waitcnt vmcnt(4)
v_max3_u32 v12, v20, v21, v22
v_max_u32 v12, v12, v23
v_cmp_eq_u32 vcc, -1, v12
s_cbranch_vccz L_fB
s_sub_u32 s63, s63, 1
s_cmp_lg_u32 s63, 0
s_cbranch_scc1 L_fpoll
L_fB:
v_add_f32 v8, v20, v21
v_add_f32 v10, v22, v23
s_branch L_fgot
L_fA:
v_add_f32 v8, v16, v17
v_add_f32 v10, v18, v19
L_fgot:
v_add_f32 v8, v8, v10
s_nop 1
v_add_f32_dpp v8, v8, v8 row_ror:8 row_mask:0xf bank_mask:0xf
v_mov_b32 v9, v8
s_nop 1
v_permlane16_swap_b32 v8, v9
s_nop 1
v_add_f32 v8, v8, v9
v_mov_b32 v9, v8
s_nop 1
v_permlane32_swap_b32 v8, v9
s_nop 1
v_add_f32 v8, v8, v9
v_cvt_pk_bf16_f32 v8, v8, v8
s_mov_b64 exec, 0xff
buffer_store_short v8, v5, s[48:51], s66 offen
L_end:
s_endpgm
.section .rodata,"a"
.p2align 6
.amdhsa_kernel gated_mix__gqa_block_cached__glu_gated_glu__decode_kernel
.amdhsa_next_free_vgpr 256
.amdhsa_next_free_sgpr 102
.amdhsa_accum_offset 256
.amdhsa_group_segment_fixed_size 0
.amdhsa_kernarg_size 104
.amdhsa_user_sgpr_count 2
.amdhsa_user_sgpr_kernarg_segment_ptr 1
.amdhsa_system_sgpr_workgroup_id_x 1
.end_amdhsa_kernel
```
